```python
import torch

def _softmax(x, axis=-1):
    return torch.softmax(x, dim=axis)
def _gelu(x):
    return torch.nn.functional.gelu(x, approximate="tanh")
def _silu(x):
    return torch.nn.functional.silu(x)
def _sigmoid(x):
    return torch.sigmoid(x)
def _layernorm(x, axis=-1, eps=1e-5):
    m = x.mean(dim=axis, keepdim=True)
    v = x.var(dim=axis, keepdim=True, unbiased=False)
    return (x - m) / torch.sqrt(v + eps)
def _scatter_add(tgt, idx, src, axis=0):
    return tgt.clone().index_add_(axis, idx, src)
def _segment_sum(src, seg, n):
    out = torch.zeros((n,) + src.shape[1:], dtype=src.dtype)
    return out.index_add_(0, seg, src)
def _pad(x, pw):
    flat = tuple(v for pair in reversed(pw) for v in pair)
    return torch.nn.functional.pad(x, flat)

kernel_name = 'standalone__edge_featured_mpnn_egc__graph'

def setup_inputs():

    _w = (lambda a: (lambda t: t.to(torch.bfloat16) if t.is_floating_point() else t)(torch.as_tensor(a)))
    N, deg, D, De = 12500, 64, 64, max(0, 1)
    E = N * deg
    return {
        "x": _w((lambda *s: torch.randn(*s, dtype=torch.bfloat16) * 0.2)(N, D)),
        "e_attr": _w((lambda *s: torch.randn(*s, dtype=torch.bfloat16) * 0.2)(E, De)),
        "src": _w((lambda lo, hi, *s: torch.randint(lo, hi, s))(0, N, E).to(torch.int64)),
        "dst": _w((lambda lo, hi, *s: torch.randint(lo, hi, s))(0, N, E).to(torch.int64)),
        "u_w": _w((lambda *s: torch.randn(*s, dtype=torch.bfloat16) * 0.05)(D, D)),
        "v_w": _w((lambda *s: torch.randn(*s, dtype=torch.bfloat16) * 0.05)(D, D)),
        "g_w": _w((lambda *s: torch.randn(*s, dtype=torch.bfloat16) * 0.2)(2 * D + De, D)),
    }

def reference(x, e_attr, src, dst, u_w, v_w, g_w):
    N, D = x.shape
    g_in = torch.concatenate([x[dst], x[src], e_attr], axis=-1)
    eta = _sigmoid(g_in @ g_w)
    hv = x @ v_w
    msg = eta * hv[src]
    agg = _segment_sum(msg, dst, N)
    return _silu(x @ u_w + agg)
```

```asm
; @launch kernel=prep_kernel grid=(250,1,1) block=(1024,1,1) lds=55296
; @launch kernel=agg_kernel grid=(250,1,1) block=(1024,1,1) lds=93184
.amdgcn_target "amdgcn-amd-amdhsa--gfx950"
.text
.globl prep_kernel
.p2align 8
.type prep_kernel,@function
prep_kernel:
  s_cmp_ge_u32 s2, 250
  s_cbranch_scc1 A_done
  s_load_dwordx16 s[4:19], s[0:1], 0
  s_load_dwordx2 s[20:21], s[0:1], 72
  v_lshrrev_b32 v1, 6, v0
  s_nop 0
  v_readfirstlane_b32 s23, v1
  s_nop 3
  s_cmp_ge_u32 s23, 8
  s_cbranch_scc1 A_gemm
  s_cmp_eq_u32 s23, 7
  s_cbranch_scc1 A_done
  s_waitcnt lgkmcnt(0)
  s_mul_i32 s22, s2, 12800
  s_add_u32 s24, s10, s22
  s_addc_u32 s25, s11, 0
  s_mov_b32 s26, 12800
  s_mov_b32 s27, 0x20000
  s_add_u32 s28, s8, s22
  s_addc_u32 s29, s9, 0
  s_mov_b32 s30, 12800
  s_mov_b32 s31, 0x20000
  s_mul_i32 s22, s2, 6400
  s_add_u32 s32, s6, s22
  s_addc_u32 s33, s7, 0
  s_mov_b32 s34, 6400
  s_mov_b32 s35, 0x20000
  v_lshlrev_b32 v1, 4, v0
  v_lshlrev_b32 v2, 5, v0
  v_cmp_gt_u32 vcc, 400, v0
  s_mov_b64 s[44:45], vcc
  s_mov_b64 exec, s[44:45]
  buffer_load_dwordx4 v[8:11], v2, s[24:27], 0 offen
  buffer_load_dwordx4 v[12:15], v2, s[24:27], 0 offen offset:16
  buffer_load_dwordx4 v[16:19], v2, s[28:31], 0 offen
  buffer_load_dwordx4 v[20:23], v2, s[28:31], 0 offen offset:16
  buffer_load_dwordx4 v[24:27], v1, s[32:35], 0 offen
  s_mov_b64 exec, -1
  s_mul_i32 s22, s2, 25600
  s_add_u32 s22, s22, 12582912
  s_add_u32 s36, s20, s22
  s_addc_u32 s37, s21, 0
  s_mov_b32 s38, 25600
  s_mov_b32 s39, 0x20000
  s_add_u32 s40, s20, 20971520
  s_addc_u32 s41, s21, 0
  s_mov_b32 s42, 262144
  s_mov_b32 s43, 0x20000
  s_mov_b32 s48, 0xffff0000
  s_and_b32 s49, s2, 63
  s_lshl_b32 s49, s49, 4
  s_lshr_b32 s50, s2, 6
  s_lshl_b32 s50, s50, 2
  s_add_u32 s49, s49, s50
  v_lshlrev_b32 v3, 2, v0
  v_mov_b32 v4, 0
  v_mov_b32 v5, 1
  ds_write_b32 v3, v4
  s_waitcnt lgkmcnt(0)
  s_barrier
  s_mov_b64 exec, s[44:45]
  s_waitcnt vmcnt(3)
  v_mul_u32_u24 v44, 5243, v8
  v_lshrrev_b32 v44, 18, v44
  v_mul_u32_u24 v60, 50, v44
  v_sub_u32 v29, v8, v60
  v_lshlrev_b32 v44, 2, v44
  ds_add_rtn_u32 v52, v44, v5
  v_mul_u32_u24 v45, 5243, v9
  v_lshrrev_b32 v45, 18, v45
  v_mul_u32_u24 v61, 50, v45
  v_sub_u32 v31, v9, v61
  v_lshlrev_b32 v45, 2, v45
  ds_add_rtn_u32 v53, v45, v5
  v_mul_u32_u24 v46, 5243, v10
  v_lshrrev_b32 v46, 18, v46
  v_mul_u32_u24 v62, 50, v46
  v_sub_u32 v33, v10, v62
  v_lshlrev_b32 v46, 2, v46
  ds_add_rtn_u32 v54, v46, v5
  v_mul_u32_u24 v47, 5243, v11
  v_lshrrev_b32 v47, 18, v47
  v_mul_u32_u24 v63, 50, v47
  v_sub_u32 v35, v11, v63
  v_lshlrev_b32 v47, 2, v47
  ds_add_rtn_u32 v55, v47, v5
  v_mul_u32_u24 v48, 5243, v12
  v_lshrrev_b32 v48, 18, v48
  v_mul_u32_u24 v64, 50, v48
  v_sub_u32 v37, v12, v64
  v_lshlrev_b32 v48, 2, v48
  ds_add_rtn_u32 v56, v48, v5
  v_mul_u32_u24 v49, 5243, v13
  v_lshrrev_b32 v49, 18, v49
  v_mul_u32_u24 v65, 50, v49
  v_sub_u32 v39, v13, v65
  v_lshlrev_b32 v49, 2, v49
  ds_add_rtn_u32 v57, v49, v5
  v_mul_u32_u24 v50, 5243, v14
  v_lshrrev_b32 v50, 18, v50
  v_mul_u32_u24 v66, 50, v50
  v_sub_u32 v41, v14, v66
  v_lshlrev_b32 v50, 2, v50
  ds_add_rtn_u32 v58, v50, v5
  v_mul_u32_u24 v51, 5243, v15
  v_lshrrev_b32 v51, 18, v51
  v_mul_u32_u24 v67, 50, v51
  v_sub_u32 v43, v15, v67
  v_lshlrev_b32 v51, 2, v51
  ds_add_rtn_u32 v59, v51, v5
  s_mov_b64 exec, -1
  s_waitcnt lgkmcnt(0)
  s_barrier
  s_cmp_lg_u32 s23, 0
  s_cbranch_scc1 A_skip3
  ds_read_b128 v[72:75], v1
  s_waitcnt lgkmcnt(0)
  v_add_u32 v77, v72, v73
  v_add_u32 v78, v77, v74
  v_add_u32 v79, v78, v75
  v_mov_b32 v80, v79
  s_nop 1
  v_add_u32_dpp v80, v80, v80 row_shr:1 row_mask:0xf bank_mask:0xf bound_ctrl:0
  s_nop 1
  v_add_u32_dpp v80, v80, v80 row_shr:2 row_mask:0xf bank_mask:0xf bound_ctrl:0
  s_nop 1
  v_add_u32_dpp v80, v80, v80 row_shr:4 row_mask:0xf bank_mask:0xf bound_ctrl:0
  s_nop 1
  v_add_u32_dpp v80, v80, v80 row_shr:8 row_mask:0xf bank_mask:0xf bound_ctrl:0
  s_nop 1
  v_add_u32_dpp v80, v80, v80 row_bcast:15 row_mask:0xa bank_mask:0xf
  s_nop 1
  v_add_u32_dpp v80, v80, v80 row_bcast:31 row_mask:0xc bank_mask:0xf
  s_nop 1
  v_sub_u32 v68, v80, v79
  v_add_u32 v69, v68, v72
  v_add_u32 v70, v68, v77
  v_add_u32 v71, v68, v78
  ds_write_b128 v1, v[68:71] offset:1024
  v_lshlrev_b32 v81, 12, v0
  v_lshl_or_b32 v72, v72, 16, v68
  buffer_store_dword v72, v81, s[40:43], s49 offen offset:0
  v_lshl_or_b32 v73, v73, 16, v69
  buffer_store_dword v73, v81, s[40:43], s49 offen offset:1024
  v_lshl_or_b32 v74, v74, 16, v70
  buffer_store_dword v74, v81, s[40:43], s49 offen offset:2048
  v_lshl_or_b32 v75, v75, 16, v71
  buffer_store_dword v75, v81, s[40:43], s49 offen offset:3072
A_skip3:
  s_waitcnt lgkmcnt(0)
  s_barrier
  s_mov_b64 exec, s[44:45]
  ds_read_b32 v60, v44 offset:1024
  ds_read_b32 v61, v45 offset:1024
  ds_read_b32 v62, v46 offset:1024
  ds_read_b32 v63, v47 offset:1024
  ds_read_b32 v64, v48 offset:1024
  ds_read_b32 v65, v49 offset:1024
  ds_read_b32 v66, v50 offset:1024
  ds_read_b32 v67, v51 offset:1024
  s_waitcnt vmcnt(0)
  v_lshl_or_b32 v28, v24, 16, v16
  v_and_or_b32 v30, v24, s48, v17
  v_lshl_or_b32 v32, v25, 16, v18
  v_and_or_b32 v34, v25, s48, v19
  v_lshl_or_b32 v36, v26, 16, v20
  v_and_or_b32 v38, v26, s48, v21
  v_lshl_or_b32 v40, v27, 16, v22
  v_and_or_b32 v42, v27, s48, v23
  s_waitcnt lgkmcnt(0)
  v_add_lshl_u32 v60, v60, v52, 3
  ds_write_b64 v60, v[28:29] offset:2048
  v_add_lshl_u32 v61, v61, v53, 3
  ds_write_b64 v61, v[30:31] offset:2048
  v_add_lshl_u32 v62, v62, v54, 3
  ds_write_b64 v62, v[32:33] offset:2048
  v_add_lshl_u32 v63, v63, v55, 3
  ds_write_b64 v63, v[34:35] offset:2048
  v_add_lshl_u32 v64, v64, v56, 3
  ds_write_b64 v64, v[36:37] offset:2048
  v_add_lshl_u32 v65, v65, v57, 3
  ds_write_b64 v65, v[38:39] offset:2048
  v_add_lshl_u32 v66, v66, v58, 3
  ds_write_b64 v66, v[40:41] offset:2048
  v_add_lshl_u32 v67, v67, v59, 3
  ds_write_b64 v67, v[42:43] offset:2048
  s_mov_b64 exec, -1
  s_waitcnt lgkmcnt(0)
  s_barrier
  ds_read_b128 v[8:11], v1 offset:2048
  ds_read_b128 v[12:15], v1 offset:9216
  ds_read_b128 v[16:19], v1 offset:16384
  ds_read_b128 v[20:23], v1 offset:23552
  s_movk_i32 s50, 0
  s_waitcnt lgkmcnt(3)
  buffer_store_dwordx4 v[8:11], v1, s[36:39], s50 offen sc1
  s_movk_i32 s50, 7168
  s_waitcnt lgkmcnt(2)
  buffer_store_dwordx4 v[12:15], v1, s[36:39], s50 offen sc1
  s_movk_i32 s50, 14336
  s_waitcnt lgkmcnt(1)
  buffer_store_dwordx4 v[16:19], v1, s[36:39], s50 offen sc1
  s_movk_i32 s50, 21504
  s_waitcnt lgkmcnt(0)
  buffer_store_dwordx4 v[20:23], v1, s[36:39], s50 offen sc1
  s_endpgm
A_gemm:
  s_waitcnt lgkmcnt(0)
  s_sub_u32 s23, s23, 8
  s_add_u32 s24, s16, 8192
  s_addc_u32 s25, s17, 0
  s_mov_b32 s26, 8192
  s_mov_b32 s27, 0x20000
  s_mov_b32 s36, s14
  s_mov_b32 s37, s15
  s_mov_b32 s38, 8192
  s_mov_b32 s39, 0x20000
  s_mov_b32 s28, s4
  s_mov_b32 s29, s5
  s_mov_b32 s30, 1600000
  s_mov_b32 s31, 0x20000
  s_add_u32 s32, s20, 0
  s_addc_u32 s33, s21, 0
  s_mov_b32 s34, 3200000
  s_mov_b32 s35, 0x20000
  v_subrev_u32 v1, 512, v0
  v_lshlrev_b32 v2, 4, v1
  buffer_load_dwordx4 v[24:27], v2, s[24:27], 0 offen
  buffer_load_dwordx4 v[28:31], v2, s[36:39], 0 offen
  s_mul_i32 s44, s2, 50
  s_lshr_b32 s45, s23, 1
  s_lshl_b32 s45, s45, 4
  s_add_u32 s44, s44, s45
  v_and_b32 v3, 15, v0
  v_bfe_u32 v4, v0, 4, 2
  v_add_u32 v5, s44, v3
  v_lshlrev_b32 v5, 7, v5
  v_lshl_add_u32 v5, v4, 4, v5
  buffer_load_dwordx4 v[16:19], v5, s[28:31], 0 offen
  buffer_load_dwordx4 v[20:23], v5, s[28:31], 0 offen offset:64
  s_barrier
  v_bfe_u32 v6, v0, 2, 2
  v_lshl_add_u32 v6, v4, 3, v6
  v_lshlrev_b32 v6, 7, v6
  v_and_b32 v7, 3, v0
  v_lshl_add_u32 v6, v7, 3, v6
  s_and_b32 s45, s23, 1
  s_lshl_b32 s47, s45, 6
  v_add_u32 v6, s47, v6
  v_lshl_add_u32 v7, v4, 2, s44
  v_lshlrev_b32 v7, 8, v7
  v_lshl_add_u32 v7, v3, 2, v7
  s_lshl_b32 s47, s45, 7
  v_add_u32 v7, s47, v7
  s_mov_b32 s46, 0xbfb8aa3b
  s_waitcnt vmcnt(2)
  ds_write_b128 v2, v[24:27] offset:36864
  ds_write_b128 v2, v[28:31] offset:46080
  s_waitcnt lgkmcnt(0)
  s_barrier
  ds_read_b64_tr_b16 v[24:25], v6 offset:36864
  ds_read_b64_tr_b16 v[26:27], v6 offset:37376
  ds_read_b64_tr_b16 v[28:29], v6 offset:40960
  ds_read_b64_tr_b16 v[30:31], v6 offset:41472
  ds_read_b64_tr_b16 v[32:33], v6 offset:46080
  ds_read_b64_tr_b16 v[34:35], v6 offset:46592
  ds_read_b64_tr_b16 v[36:37], v6 offset:50176
  ds_read_b64_tr_b16 v[38:39], v6 offset:50688
  ds_read_b64_tr_b16 v[40:41], v6 offset:36896
  ds_read_b64_tr_b16 v[42:43], v6 offset:37408
  ds_read_b64_tr_b16 v[44:45], v6 offset:40992
  ds_read_b64_tr_b16 v[46:47], v6 offset:41504
  ds_read_b64_tr_b16 v[48:49], v6 offset:46112
  ds_read_b64_tr_b16 v[50:51], v6 offset:46624
  ds_read_b64_tr_b16 v[52:53], v6 offset:50208
  ds_read_b64_tr_b16 v[54:55], v6 offset:50720
  s_waitcnt vmcnt(0) lgkmcnt(0)
  v_mfma_f32_16x16x32_bf16 v[56:59], v[16:19], v[24:27], 0
  v_mfma_f32_16x16x32_bf16 v[60:63], v[16:19], v[32:35], 0
  v_mfma_f32_16x16x32_bf16 v[56:59], v[20:23], v[28:31], v[56:59]
  v_mfma_f32_16x16x32_bf16 v[60:63], v[20:23], v[36:39], v[60:63]
  v_mfma_f32_16x16x32_bf16 v[64:67], v[16:19], v[40:43], 0
  v_mfma_f32_16x16x32_bf16 v[68:71], v[16:19], v[48:51], 0
  v_mfma_f32_16x16x32_bf16 v[64:67], v[20:23], v[44:47], v[64:67]
  v_mfma_f32_16x16x32_bf16 v[68:71], v[20:23], v[52:55], v[68:71]
  s_barrier
  s_nop 7
  s_nop 3
  v_mul_f32 v56, s46, v56
  v_mul_f32 v57, s46, v57
  v_mul_f32 v58, s46, v58
  v_mul_f32 v59, s46, v59
  v_cvt_pk_bf16_f32 v72, v60, v60
  v_and_b32 v72, 0xffff, v72
  v_and_b32 v60, 0x7fffffff, v56
  v_sub_u32 v60, v60, v72
  v_add_u32 v60, 0x8000, v60
  v_max_i32 v60, 0, v60
  v_and_b32 v60, 0xffff0000, v60
  v_and_b32 v56, 0x80000000, v56
  v_or3_b32 v72, v60, v56, v72
  v_cvt_pk_bf16_f32 v73, v61, v61
  v_and_b32 v73, 0xffff, v73
  v_and_b32 v61, 0x7fffffff, v57
  v_sub_u32 v61, v61, v73
  v_add_u32 v61, 0x8000, v61
  v_max_i32 v61, 0, v61
  v_and_b32 v61, 0xffff0000, v61
  v_and_b32 v57, 0x80000000, v57
  v_or3_b32 v73, v61, v57, v73
  v_cvt_pk_bf16_f32 v74, v62, v62
  v_and_b32 v74, 0xffff, v74
  v_and_b32 v62, 0x7fffffff, v58
  v_sub_u32 v62, v62, v74
  v_add_u32 v62, 0x8000, v62
  v_max_i32 v62, 0, v62
  v_and_b32 v62, 0xffff0000, v62
  v_and_b32 v58, 0x80000000, v58
  v_or3_b32 v74, v62, v58, v74
  v_cvt_pk_bf16_f32 v75, v63, v63
  v_and_b32 v75, 0xffff, v75
  v_and_b32 v63, 0x7fffffff, v59
  v_sub_u32 v63, v63, v75
  v_add_u32 v63, 0x8000, v63
  v_max_i32 v63, 0, v63
  v_and_b32 v63, 0xffff0000, v63
  v_and_b32 v59, 0x80000000, v59
  v_or3_b32 v75, v63, v59, v75
  buffer_store_dword v72, v7, s[32:35], 0 offen offset:0 sc1
  buffer_store_dword v73, v7, s[32:35], 0 offen offset:256 sc1
  buffer_store_dword v74, v7, s[32:35], 0 offen offset:512 sc1
  buffer_store_dword v75, v7, s[32:35], 0 offen offset:768 sc1
  v_mul_f32 v64, s46, v64
  v_mul_f32 v65, s46, v65
  v_mul_f32 v66, s46, v66
  v_mul_f32 v67, s46, v67
  v_cvt_pk_bf16_f32 v72, v68, v68
  v_and_b32 v72, 0xffff, v72
  v_and_b32 v68, 0x7fffffff, v64
  v_sub_u32 v68, v68, v72
  v_add_u32 v68, 0x8000, v68
  v_max_i32 v68, 0, v68
  v_and_b32 v68, 0xffff0000, v68
  v_and_b32 v64, 0x80000000, v64
  v_or3_b32 v72, v68, v64, v72
  v_cvt_pk_bf16_f32 v73, v69, v69
  v_and_b32 v73, 0xffff, v73
  v_and_b32 v69, 0x7fffffff, v65
  v_sub_u32 v69, v69, v73
  v_add_u32 v69, 0x8000, v69
  v_max_i32 v69, 0, v69
  v_and_b32 v69, 0xffff0000, v69
  v_and_b32 v65, 0x80000000, v65
  v_or3_b32 v73, v69, v65, v73
  v_cvt_pk_bf16_f32 v74, v70, v70
  v_and_b32 v74, 0xffff, v74
  v_and_b32 v70, 0x7fffffff, v66
  v_sub_u32 v70, v70, v74
  v_add_u32 v70, 0x8000, v70
  v_max_i32 v70, 0, v70
  v_and_b32 v70, 0xffff0000, v70
  v_and_b32 v66, 0x80000000, v66
  v_or3_b32 v74, v70, v66, v74
  v_cvt_pk_bf16_f32 v75, v71, v71
  v_and_b32 v75, 0xffff, v75
  v_and_b32 v71, 0x7fffffff, v67
  v_sub_u32 v71, v71, v75
  v_add_u32 v71, 0x8000, v71
  v_max_i32 v71, 0, v71
  v_and_b32 v71, 0xffff0000, v71
  v_and_b32 v67, 0x80000000, v67
  v_or3_b32 v75, v71, v67, v75
  buffer_store_dword v72, v7, s[32:35], 0 offen offset:64 sc1
  buffer_store_dword v73, v7, s[32:35], 0 offen offset:320 sc1
  buffer_store_dword v74, v7, s[32:35], 0 offen offset:576 sc1
  buffer_store_dword v75, v7, s[32:35], 0 offen offset:832 sc1
A_done:
  s_endpgm
.globl agg_kernel
.p2align 8
.type agg_kernel,@function
agg_kernel:
  s_cmp_ge_u32 s2, 250
  s_cbranch_scc1 B_done
  s_load_dwordx4 s[4:7], s[0:1], 48
  s_load_dwordx2 s[8:9], s[0:1], 72
  s_load_dwordx2 s[10:11], s[0:1], 0
  s_load_dwordx2 s[46:47], s[0:1], 32
  s_and_b32 s3, s2, 7
  s_lshr_b32 s2, s2, 3
  s_mov_b32 s96, s2
  s_mul_i32 s44, s3, 31
  s_min_u32 s3, s3, 2
  s_add_u32 s2, s2, s44
  s_add_u32 s2, s2, s3
  v_lshrrev_b32 v3, 6, v0
  v_and_b32 v1, 15, v0
  v_readfirstlane_b32 s40, v3
  v_lshlrev_b32 v1, 4, v1
  v_and_b32 v2, 63, v0
  s_waitcnt lgkmcnt(0)
  v_lshrrev_b32 v3, 4, v0
  s_add_u32 s20, s8, 20971520
  s_addc_u32 s21, s9, 0
  s_mov_b32 s22, 262144
  s_mov_b32 s23, 0x20000
  v_lshlrev_b32 v124, 4, v3
  s_lshl_b32 s50, s2, 10
  buffer_load_dwordx4 v[4:7], v124, s[20:23], s50 offen
  s_add_u32 s12, s8, 0
  s_addc_u32 s13, s9, 0
  s_or_b32 s13, s13, 0x01000000
  s_mov_b32 s14, 12500
  s_mov_b32 s15, 0x20000
  s_add_u32 s16, s8, 12582912
  s_addc_u32 s17, s9, 0
  s_mov_b32 s18, 6400000
  s_mov_b32 s19, 0x20000
  s_mov_b32 s24, s10
  s_mov_b32 s25, s11
  s_mov_b32 s26, 1600000
  s_mov_b32 s27, 0x20000
  s_cmp_lt_u32 s40, 8
  s_cselect_b32 s28, s4, s46
  s_cselect_b32 s29, s5, s47
  s_mov_b32 s30, 8192
  s_mov_b32 s31, 0x20000
  s_mov_b32 s32, s6
  s_mov_b32 s33, s7
  s_mov_b32 s34, 1600000
  s_mov_b32 s35, 0x20000
  s_mov_b32 s36, s4
  s_mov_b32 s37, s5
  s_mov_b32 s38, 16512
  s_mov_b32 s39, 0x20000
  s_and_b32 s55, s40, 7
  s_mov_b32 s98, 83968
  s_mov_b32 s48, 0x3f80
  s_mov_b32 s49, 0xffff0000
  s_mov_b32 s51, 0xbfb8aa3b
  v_lshlrev_b32 v91, 4, v0
  v_bfe_u32 v88, v0, 4, 2
  v_and_b32 v52, 15, v0
  v_and_b32 v53, 511, v0
  v_lshlrev_b32 v53, 4, v53
  buffer_load_dwordx4 v[8:11], v53, s[28:31], 0 offen
  s_mul_i32 s52, s2, 6400
  v_lshlrev_b32 v53, 3, v0
  buffer_load_dwordx2 v[12:13], v53, s[24:27], s52 offen
  v_lshrrev_b32 v90, 1, v1
  v_add_u32 v90, 16384, v90
  buffer_load_dwordx2 v[44:45], v90, s[36:39], 0 offen
  v_mov_b32 v48, 0xffff
  v_mov_b32 v49, 0xffff
  v_mov_b32 v50, 0xffff
  v_mov_b32 v51, 0xffff
  ds_write_b128 v91, v[48:51] offset:33792
  ds_write_b128 v91, v[48:51] offset:50176
  v_lshlrev_b32 v53, 4, v2
  v_add_u32 v53, 66560, v53
  ds_write_b128 v53, v[48:51]
  v_lshlrev_b32 v53, 2, v2
  v_mov_b32 v54, 0
  ds_write_b32 v53, v54 offset:0
  v_mov_b32 v53, 256
  s_mov_b64 exec, 1
  ds_write_b32 v53, v54
  s_mov_b64 exec, -1
  v_mov_b32 v100, 0
  v_mov_b32 v102, 0
  v_mov_b32 v104, 0
  v_mov_b32 v106, 0
  v_mov_b32 v108, 0
  v_mov_b32 v110, 0
  v_mov_b32 v112, 0
  v_mov_b32 v114, 0
  v_mov_b32 v117, v1
  v_mov_b32 v119, v1
  v_mov_b32 v121, v1
  v_mov_b32 v123, v1
  v_mov_b32 v126, 1.0
  v_mov_b32 v127, 1.0
  v_mov_b32 v125, 1
  s_mov_b32 s45, 25600
  v_lshlrev_b32 v55, 1, v52
  s_waitcnt lgkmcnt(0)
  s_barrier
  v_cmp_gt_u32 vcc, 58, v3
  s_waitcnt vmcnt(3)
  s_nop 0
  v_cndmask_b32 v7, 0, v7, vcc
  v_add_u32 v53, 0, v3
  v_mul_lo_u32 v53, v53, s45
  v_and_b32 v54, 0xffff, v4
  v_add_u32 v54, v54, v55
  v_lshl_add_u32 v92, v54, 3, v53
  v_lshrrev_b32 v4, 16, v4
  v_sub_u32 v96, v4, v55
  v_add_u32 v53, 64, v3
  v_mul_lo_u32 v53, v53, s45
  v_and_b32 v54, 0xffff, v5
  v_add_u32 v54, v54, v55
  v_lshl_add_u32 v93, v54, 3, v53
  v_lshrrev_b32 v5, 16, v5
  v_sub_u32 v97, v5, v55
  v_add_u32 v53, 128, v3
  v_mul_lo_u32 v53, v53, s45
  v_and_b32 v54, 0xffff, v6
  v_add_u32 v54, v54, v55
  v_lshl_add_u32 v94, v54, 3, v53
  v_lshrrev_b32 v6, 16, v6
  v_sub_u32 v98, v6, v55
  v_add_u32 v53, 192, v3
  v_mul_lo_u32 v53, v53, s45
  v_and_b32 v54, 0xffff, v7
  v_add_u32 v54, v54, v55
  v_lshl_add_u32 v95, v54, 3, v53
  v_lshrrev_b32 v7, 16, v7
  v_sub_u32 v99, v7, v55
  s_mov_b32 s41, 0
  s_lshl_b32 s50, s41, 3
  s_add_u32 s52, s41, 1
  v_cmp_lt_i32 s[56:57], s41, v96
  v_cmp_lt_i32 s[58:59], s52, v96
  v_cmp_lt_i32 s[60:61], s41, v97
  v_cmp_lt_i32 s[62:63], s52, v97
  v_cmp_lt_i32 s[64:65], s41, v98
  v_cmp_lt_i32 s[66:67], s52, v98
  v_cmp_lt_i32 s[68:69], s41, v99
  v_cmp_lt_i32 s[70:71], s52, v99
  s_nop 3
  s_or_b64 exec, s[56:57], 1
  buffer_load_dwordx4 v[16:19], v92, s[16:19], s50 offen
  s_or_b64 exec, s[60:61], 1
  buffer_load_dwordx4 v[20:23], v93, s[16:19], s50 offen
  s_or_b64 exec, s[64:65], 1
  buffer_load_dwordx4 v[24:27], v94, s[16:19], s50 offen
  s_or_b64 exec, s[68:69], 1
  buffer_load_dwordx4 v[28:31], v95, s[16:19], s50 offen
  s_mov_b64 exec, -1
  v_max_u32 v4, v4, v5
  v_max_u32 v6, v6, v7
  v_max_u32 v4, v4, v6
  s_nop 1
  v_max_u32_dpp v4, v4, v4 row_bcast:15 row_mask:0xa bank_mask:0xf
  s_nop 1
  v_max_u32_dpp v4, v4, v4 row_bcast:31 row_mask:0xc bank_mask:0xf
  s_nop 1
  v_readlane_b32 s44, v4, 63
  s_nop 3
  v_mov_b32 v4, s44
  v_mov_b32 v53, 256
  s_mov_b64 exec, 1
  ds_max_u32 v53, v4
  s_mov_b64 exec, -1
  s_cmp_lt_u32 s55, 4
  s_mov_b32 s52, 17408
  s_cselect_b32 s52, 1024, s52
  s_cselect_b32 s97, s51, 1.0
  s_lshr_b32 s53, s40, 3
  s_lshl_b32 s53, s53, 13
  s_add_u32 s52, s52, s53
  s_and_b32 s54, s55, 3
  s_lshl_b32 s54, s54, 6
  s_add_u32 s52, s52, s54
  v_lshlrev_b32 v5, 10, v88
  v_lshl_add_u32 v5, v52, 2, v5
  v_add_u32 v5, s52, v5
  v_lshlrev_b32 v88, 2, v88
  v_lshrrev_b32 v54, 4, v0
  v_mul_u32_u24 v54, 144, v54
  v_lshrrev_b32 v53, 1, v1
  v_add3_u32 v54, v54, v53, s98
  s_waitcnt vmcnt(4)
  v_add_u32 v53, 67584, v91
  ds_write_b128 v53, v[8:11]
  ds_write_b64 v54, v[12:13]
  s_waitcnt vmcnt(0)
  s_branch B_count
B_layer:
  v_mov_b32 v48, 0xffff
  v_mov_b32 v49, 0xffff
  v_mov_b32 v50, 0xffff
  v_mov_b32 v51, 0xffff
  ds_write_b128 v91, v[48:51] offset:33792
  ds_write_b128 v91, v[48:51] offset:50176
  v_lshlrev_b32 v53, 4, v2
  v_add_u32 v53, 66560, v53
  ds_write_b128 v53, v[48:51]
  v_lshlrev_b32 v53, 2, v2
  v_mov_b32 v54, 0
  ds_write_b32 v53, v54 offset:0
  s_waitcnt lgkmcnt(0)
  s_barrier
  s_lshl_b32 s50, s41, 3
  s_add_u32 s52, s41, 1
  v_cmp_lt_i32 s[56:57], s41, v96
  v_cmp_lt_i32 s[58:59], s52, v96
  v_cmp_lt_i32 s[60:61], s41, v97
  v_cmp_lt_i32 s[62:63], s52, v97
  v_cmp_lt_i32 s[64:65], s41, v98
  v_cmp_lt_i32 s[66:67], s52, v98
  v_cmp_lt_i32 s[68:69], s41, v99
  v_cmp_lt_i32 s[70:71], s52, v99
  s_nop 3
  s_or_b64 exec, s[56:57], 1
  buffer_load_dwordx4 v[16:19], v92, s[16:19], s50 offen
  s_or_b64 exec, s[60:61], 1
  buffer_load_dwordx4 v[20:23], v93, s[16:19], s50 offen
  s_or_b64 exec, s[64:65], 1
  buffer_load_dwordx4 v[24:27], v94, s[16:19], s50 offen
  s_or_b64 exec, s[68:69], 1
  buffer_load_dwordx4 v[28:31], v95, s[16:19], s50 offen
  s_mov_b64 exec, -1
  s_waitcnt vmcnt(0)
B_count:
  v_lshlrev_b32 v17, 2, v17
  s_mov_b64 exec, s[56:57]
  ds_add_rtn_u32 v32, v17, v125 offset:0
  s_mov_b64 exec, -1
  v_lshlrev_b32 v19, 2, v19
  s_mov_b64 exec, s[58:59]
  ds_add_rtn_u32 v33, v19, v125 offset:0
  s_mov_b64 exec, -1
  v_lshlrev_b32 v21, 2, v21
  s_mov_b64 exec, s[60:61]
  ds_add_rtn_u32 v34, v21, v125 offset:0
  s_mov_b64 exec, -1
  v_lshlrev_b32 v23, 2, v23
  s_mov_b64 exec, s[62:63]
  ds_add_rtn_u32 v35, v23, v125 offset:0
  s_mov_b64 exec, -1
  v_lshlrev_b32 v25, 2, v25
  s_mov_b64 exec, s[64:65]
  ds_add_rtn_u32 v36, v25, v125 offset:0
  s_mov_b64 exec, -1
  v_lshlrev_b32 v27, 2, v27
  s_mov_b64 exec, s[66:67]
  ds_add_rtn_u32 v37, v27, v125 offset:0
  s_mov_b64 exec, -1
  v_lshlrev_b32 v29, 2, v29
  s_mov_b64 exec, s[68:69]
  ds_add_rtn_u32 v38, v29, v125 offset:0
  s_mov_b64 exec, -1
  v_lshlrev_b32 v31, 2, v31
  s_mov_b64 exec, s[70:71]
  ds_add_rtn_u32 v39, v31, v125 offset:0
  s_mov_b64 exec, -1
  s_waitcnt lgkmcnt(0)
  s_barrier
  v_lshlrev_b32 v52, 2, v2
  ds_read_b32 v53, v52 offset:0
  v_mov_b32 v52, 256
  ds_read_b32 v54, v52
  v_cmp_gt_u32 vcc, 50, v2
  s_waitcnt lgkmcnt(0)
  v_readfirstlane_b32 s42, v54
  v_cndmask_b32 v53, 0, v53, vcc
  v_add_u32 v53, 3, v53
  v_lshrrev_b32 v53, 2, v53
  v_mov_b32 v54, v53
  s_nop 1
  v_add_u32_dpp v54, v54, v54 row_shr:1 row_mask:0xf bank_mask:0xf bound_ctrl:0
  s_nop 1
  v_add_u32_dpp v54, v54, v54 row_shr:2 row_mask:0xf bank_mask:0xf bound_ctrl:0
  s_nop 1
  v_add_u32_dpp v54, v54, v54 row_shr:4 row_mask:0xf bank_mask:0xf bound_ctrl:0
  s_nop 1
  v_add_u32_dpp v54, v54, v54 row_shr:8 row_mask:0xf bank_mask:0xf bound_ctrl:0
  s_nop 1
  v_add_u32_dpp v54, v54, v54 row_bcast:15 row_mask:0xa bank_mask:0xf
  s_nop 1
  v_add_u32_dpp v54, v54, v54 row_bcast:31 row_mask:0xc bank_mask:0xf
  s_nop 1
  v_sub_u32 v89, v54, v53
  v_readlane_b32 s43, v54, 63
  ds_bpermute_b32 v72, v17, v89
  ds_bpermute_b32 v73, v19, v89
  ds_bpermute_b32 v74, v21, v89
  ds_bpermute_b32 v75, v23, v89
  ds_bpermute_b32 v76, v25, v89
  ds_bpermute_b32 v77, v27, v89
  ds_bpermute_b32 v78, v29, v89
  ds_bpermute_b32 v79, v31, v89
  s_waitcnt lgkmcnt(0)
  v_lshl_add_u32 v72, v72, 2, v32
  v_lshlrev_b32 v72, 2, v72
  s_mov_b64 exec, s[56:57]
  ds_write_b32 v72, v16 offset:33792
  s_mov_b64 exec, -1
  v_lshl_add_u32 v73, v73, 2, v33
  v_lshlrev_b32 v73, 2, v73
  s_mov_b64 exec, s[58:59]
  ds_write_b32 v73, v18 offset:33792
  s_mov_b64 exec, -1
  v_lshl_add_u32 v74, v74, 2, v34
  v_lshlrev_b32 v74, 2, v74
  s_mov_b64 exec, s[60:61]
  ds_write_b32 v74, v20 offset:33792
  s_mov_b64 exec, -1
  v_lshl_add_u32 v75, v75, 2, v35
  v_lshlrev_b32 v75, 2, v75
  s_mov_b64 exec, s[62:63]
  ds_write_b32 v75, v22 offset:33792
  s_mov_b64 exec, -1
  v_lshl_add_u32 v76, v76, 2, v36
  v_lshlrev_b32 v76, 2, v76
  s_mov_b64 exec, s[64:65]
  ds_write_b32 v76, v24 offset:33792
  s_mov_b64 exec, -1
  v_lshl_add_u32 v77, v77, 2, v37
  v_lshlrev_b32 v77, 2, v77
  s_mov_b64 exec, s[66:67]
  ds_write_b32 v77, v26 offset:33792
  s_mov_b64 exec, -1
  v_lshl_add_u32 v78, v78, 2, v38
  v_lshlrev_b32 v78, 2, v78
  s_mov_b64 exec, s[68:69]
  ds_write_b32 v78, v28 offset:33792
  s_mov_b64 exec, -1
  v_lshl_add_u32 v79, v79, 2, v39
  v_lshlrev_b32 v79, 2, v79
  s_mov_b64 exec, s[70:71]
  ds_write_b32 v79, v30 offset:33792
  s_mov_b64 exec, -1
  s_cmp_lg_u32 s41, 0
  s_cbranch_scc1 B_nomfma
  s_mul_i32 s50, s96, 404
  v_lshrrev_b32 v20, 4, v0
  v_add_u32 v20, s50, v20
  v_mov_b32 v21, v1
  buffer_load_dwordx4 v[16:19], v[20:21], s[12:15], 0 idxen offen
  v_add_u32 v20, 64, v20
  buffer_load_dwordx4 v[16:19], v[20:21], s[12:15], 0 idxen offen
  v_add_u32 v20, 64, v20
  v_bfe_u32 v53, v0, 2, 2
  v_bfe_u32 v54, v0, 4, 2
  v_lshl_add_u32 v53, v54, 3, v53
  v_lshlrev_b32 v53, 7, v53
  v_and_b32 v54, 3, v0
  v_lshl_add_u32 v53, v54, 3, v53
  s_lshr_b32 s52, s55, 2
  s_lshl_b32 s52, s52, 13
  s_and_b32 s54, s55, 3
  s_lshl_b32 s54, s54, 5
  s_add_u32 s52, s52, s54
  s_add_u32 s52, s52, 67584
  v_add_u32 v53, s52, v53
  ds_read_b64_tr_b16 v[8:9], v53 offset:0
  ds_read_b64_tr_b16 v[10:11], v53 offset:512
  ds_read_b64_tr_b16 v[12:13], v53 offset:4096
  ds_read_b64_tr_b16 v[14:15], v53 offset:4608
  v_and_b32 v53, 15, v0
  s_lshr_b32 s52, s40, 3
  s_lshl_b32 s52, s52, 5
  v_add_u32 v53, s52, v53
  v_mul_u32_u24 v53, 144, v53
  v_bfe_u32 v54, v0, 4, 2
  v_lshl_add_u32 v53, v54, 4, v53
  v_add_u32 v53, s98, v53
  ds_read_b128 v[56:59], v53
  ds_read_b128 v[60:63], v53 offset:64
  ds_read_b128 v[64:67], v53 offset:2304
  ds_read_b128 v[68:71], v53 offset:2368
  s_waitcnt lgkmcnt(0)
  v_mfma_f32_16x16x32_bf16 v[80:83], v[56:59], v[8:11], 0
  v_mfma_f32_16x16x32_bf16 v[84:87], v[64:67], v[8:11], 0
  v_mfma_f32_16x16x32_bf16 v[80:83], v[60:63], v[12:15], v[80:83]
  v_mfma_f32_16x16x32_bf16 v[84:87], v[68:71], v[12:15], v[84:87]
  s_nop 7
  s_nop 1
  v_mul_f32 v80, s97, v80
  v_mul_f32 v81, s97, v81
  v_mul_f32 v82, s97, v82
  v_mul_f32 v83, s97, v83
  v_mul_f32 v84, s97, v84
  v_mul_f32 v85, s97, v85
  v_mul_f32 v86, s97, v86
  v_mul_f32 v87, s97, v87
  ds_write_b32 v5, v80 offset:0
  ds_write_b32 v5, v84 offset:4096
  ds_write_b32 v5, v81 offset:256
  ds_write_b32 v5, v85 offset:4352
  ds_write_b32 v5, v82 offset:512
  ds_write_b32 v5, v86 offset:4608
  ds_write_b32 v5, v83 offset:768
  ds_write_b32 v5, v87 offset:4864
  v_lshlrev_b32 v12, 16, v44
  v_and_b32 v13, s49, v44
  v_lshlrev_b32 v14, 16, v45
  v_and_b32 v15, s49, v45
  v_mul_f32 v12, s51, v12
  v_mul_f32 v13, s51, v13
  v_mul_f32 v14, s51, v14
  v_mul_f32 v15, s51, v15
B_nomfma:
  s_waitcnt lgkmcnt(0)
  s_barrier
  s_mul_i32 s44, s43, s40
  s_lshr_b32 s44, s44, 4
  s_add_u32 s45, s40, 1
  s_mul_i32 s45, s43, s45
  s_lshr_b32 s45, s45, 4
  s_cmp_eq_u32 s44, s45
  s_cbranch_scc1 B_loop_end
  s_lshl_b32 s50, s44, 4
  v_add_u32 v90, s50, v88
  s_sub_u32 s50, s45, s44
  s_mul_i32 s52, s50, 16
  s_lshr_b32 s52, s52, 6
  s_add_u32 s52, s52, s44
  s_mul_i32 s53, s50, 32
  s_lshr_b32 s53, s53, 6
  s_add_u32 s53, s53, s44
  s_mul_i32 s54, s50, 48
  s_lshr_b32 s54, s54, 6
  s_add_u32 s54, s54, s44
  s_setprio 3
  ds_read_u16 v116, v90 offset:33792
  ds_read_u16 v118, v90 offset:33808
  ds_read_u16 v120, v90 offset:33824
  ds_read_u16 v122, v90 offset:33840
  s_waitcnt lgkmcnt(0)
  buffer_load_dwordx4 v[56:59], v[116:117], s[12:15], 0 idxen offen
  buffer_load_dwordx4 v[60:63], v[118:119], s[12:15], 0 idxen offen
  buffer_load_dwordx4 v[64:67], v[120:121], s[12:15], 0 idxen offen
  buffer_load_dwordx4 v[68:71], v[122:123], s[12:15], 0 idxen offen
  ds_read_u16 v116, v90 offset:33856
  ds_read_u16 v118, v90 offset:33872
  ds_read_u16 v120, v90 offset:33888
  ds_read_u16 v122, v90 offset:33904
  s_waitcnt lgkmcnt(0)
  buffer_load_dwordx4 v[72:75], v[116:117], s[12:15], 0 idxen offen
  buffer_load_dwordx4 v[76:79], v[118:119], s[12:15], 0 idxen offen
  buffer_load_dwordx4 v[80:83], v[120:121], s[12:15], 0 idxen offen
  buffer_load_dwordx4 v[84:87], v[122:123], s[12:15], 0 idxen offen
  ds_read_u16 v116, v90 offset:33920
  ds_read_u16_d16_hi v100, v90 offset:33794
  ds_read_u16 v118, v90 offset:33936
  ds_read_u16_d16_hi v102, v90 offset:33810
  ds_read_u16 v120, v90 offset:33952
  ds_read_u16_d16_hi v104, v90 offset:33826
  ds_read_u16 v122, v90 offset:33968
  ds_read_u16_d16_hi v106, v90 offset:33842
  v_cmp_ge_u32 vcc, s44, v89
  s_nop 3
  s_bcnt1_i32_b64 s47, vcc
  v_readlane_b32 s46, v89, s47
  s_sub_u32 s47, s47, 1
  s_lshl_b32 s50, s47, 8
  v_add_u32 v124, s50, v1
  ds_read_b128 v[40:43], v124 offset:1024
  s_min_u32 s46, s46, s45
  v_mov_b32 v44, 0
  v_mov_b32 v45, 0
  v_mov_b32 v46, 0
  v_mov_b32 v47, 0
  s_waitcnt lgkmcnt(0)
B_loop:
  s_cmp_ge_u32 s44, s52
  s_cbranch_scc0 B_prio_done
  s_setprio 2
  s_cmp_ge_u32 s44, s53
  s_cbranch_scc0 B_prio_done
  s_setprio 1
  s_cmp_ge_u32 s44, s54
  s_cbranch_scc0 B_prio_done
  s_setprio 0
B_prio_done:
  s_cmp_eq_u32 s44, s46
  s_cbranch_scc1 B_switch0
B_cont0:
  s_waitcnt vmcnt(7) lgkmcnt(6)
  v_pk_fma_f32 v[48:49], v[100:101], v[12:13], v[40:41] op_sel_hi:[0,1,1]
  v_pk_fma_f32 v[50:51], v[100:101], v[14:15], v[42:43] op_sel_hi:[0,1,1]
  v_pk_add_f32 v[48:49], v[48:49], v[56:57]
  v_pk_add_f32 v[50:51], v[50:51], v[58:59]
  v_exp_f32 v48, v48
  v_exp_f32 v49, v49
  v_exp_f32 v50, v50
  v_exp_f32 v51, v51
  v_pk_add_f32 v[48:49], v[48:49], v[126:127]
  v_pk_add_f32 v[50:51], v[50:51], v[126:127]
  v_rcp_f32 v48, v48
  v_rcp_f32 v49, v49
  v_rcp_f32 v50, v50
  v_rcp_f32 v51, v51
  v_lshlrev_b32 v52, 16, v56
  v_lshlrev_b32 v53, 16, v57
  v_lshlrev_b32 v54, 16, v58
  v_lshlrev_b32 v55, 16, v59
  v_pk_fma_f32 v[44:45], v[52:53], v[48:49], v[44:45]
  v_pk_fma_f32 v[46:47], v[54:55], v[50:51], v[46:47]
  buffer_load_dwordx4 v[56:59], v[116:117], s[12:15], 0 idxen offen
  ds_read_u16 v116, v90 offset:33984
  ds_read_u16_d16_hi v108, v90 offset:33858
  s_add_u32 s44, s44, 1
  s_cmp_eq_u32 s44, s46
  s_cbranch_scc1 B_switch1
B_cont1:
  s_waitcnt vmcnt(7) lgkmcnt(6)
  v_pk_fma_f32 v[48:49], v[102:103], v[12:13], v[40:41] op_sel_hi:[0,1,1]
  v_pk_fma_f32 v[50:51], v[102:103], v[14:15], v[42:43] op_sel_hi:[0,1,1]
  v_pk_add_f32 v[48:49], v[48:49], v[60:61]
  v_pk_add_f32 v[50:51], v[50:51], v[62:63]
  v_exp_f32 v48, v48
  v_exp_f32 v49, v49
  v_exp_f32 v50, v50
  v_exp_f32 v51, v51
  v_pk_add_f32 v[48:49], v[48:49], v[126:127]
  v_pk_add_f32 v[50:51], v[50:51], v[126:127]
  v_rcp_f32 v48, v48
  v_rcp_f32 v49, v49
  v_rcp_f32 v50, v50
  v_rcp_f32 v51, v51
  v_lshlrev_b32 v52, 16, v60
  v_lshlrev_b32 v53, 16, v61
  v_lshlrev_b32 v54, 16, v62
  v_lshlrev_b32 v55, 16, v63
  v_pk_fma_f32 v[44:45], v[52:53], v[48:49], v[44:45]
  v_pk_fma_f32 v[46:47], v[54:55], v[50:51], v[46:47]
  buffer_load_dwordx4 v[60:63], v[118:119], s[12:15], 0 idxen offen
  ds_read_u16 v118, v90 offset:34000
  ds_read_u16_d16_hi v110, v90 offset:33874
  s_add_u32 s44, s44, 1
  s_cmp_eq_u32 s44, s46
  s_cbranch_scc1 B_switch2
B_cont2:
  s_waitcnt vmcnt(7) lgkmcnt(6)
  v_pk_fma_f32 v[48:49], v[104:105], v[12:13], v[40:41] op_sel_hi:[0,1,1]
  v_pk_fma_f32 v[50:51], v[104:105], v[14:15], v[42:43] op_sel_hi:[0,1,1]
  v_pk_add_f32 v[48:49], v[48:49], v[64:65]
  v_pk_add_f32 v[50:51], v[50:51], v[66:67]
  v_exp_f32 v48, v48
  v_exp_f32 v49, v49
  v_exp_f32 v50, v50
  v_exp_f32 v51, v51
  v_pk_add_f32 v[48:49], v[48:49], v[126:127]
  v_pk_add_f32 v[50:51], v[50:51], v[126:127]
  v_rcp_f32 v48, v48
  v_rcp_f32 v49, v49
  v_rcp_f32 v50, v50
  v_rcp_f32 v51, v51
  v_lshlrev_b32 v52, 16, v64
  v_lshlrev_b32 v53, 16, v65
  v_lshlrev_b32 v54, 16, v66
  v_lshlrev_b32 v55, 16, v67
  v_pk_fma_f32 v[44:45], v[52:53], v[48:49], v[44:45]
  v_pk_fma_f32 v[46:47], v[54:55], v[50:51], v[46:47]
  buffer_load_dwordx4 v[64:67], v[120:121], s[12:15], 0 idxen offen
  ds_read_u16 v120, v90 offset:34016
  ds_read_u16_d16_hi v112, v90 offset:33890
  s_add_u32 s44, s44, 1
  s_cmp_eq_u32 s44, s46
  s_cbranch_scc1 B_switch3
B_cont3:
  s_waitcnt vmcnt(7) lgkmcnt(6)
  v_pk_fma_f32 v[48:49], v[106:107], v[12:13], v[40:41] op_sel_hi:[0,1,1]
  v_pk_fma_f32 v[50:51], v[106:107], v[14:15], v[42:43] op_sel_hi:[0,1,1]
  v_pk_add_f32 v[48:49], v[48:49], v[68:69]
  v_pk_add_f32 v[50:51], v[50:51], v[70:71]
  v_exp_f32 v48, v48
  v_exp_f32 v49, v49
  v_exp_f32 v50, v50
  v_exp_f32 v51, v51
  v_pk_add_f32 v[48:49], v[48:49], v[126:127]
  v_pk_add_f32 v[50:51], v[50:51], v[126:127]
  v_rcp_f32 v48, v48
  v_rcp_f32 v49, v49
  v_rcp_f32 v50, v50
  v_rcp_f32 v51, v51
  v_lshlrev_b32 v52, 16, v68
  v_lshlrev_b32 v53, 16, v69
  v_lshlrev_b32 v54, 16, v70
  v_lshlrev_b32 v55, 16, v71
  v_pk_fma_f32 v[44:45], v[52:53], v[48:49], v[44:45]
  v_pk_fma_f32 v[46:47], v[54:55], v[50:51], v[46:47]
  buffer_load_dwordx4 v[68:71], v[122:123], s[12:15], 0 idxen offen
  ds_read_u16 v122, v90 offset:34032
  ds_read_u16_d16_hi v114, v90 offset:33906
  s_add_u32 s44, s44, 1
  s_cmp_eq_u32 s44, s46
  s_cbranch_scc1 B_switch4
B_cont4:
  s_waitcnt vmcnt(7) lgkmcnt(6)
  v_pk_fma_f32 v[48:49], v[108:109], v[12:13], v[40:41] op_sel_hi:[0,1,1]
  v_pk_fma_f32 v[50:51], v[108:109], v[14:15], v[42:43] op_sel_hi:[0,1,1]
  v_pk_add_f32 v[48:49], v[48:49], v[72:73]
  v_pk_add_f32 v[50:51], v[50:51], v[74:75]
  v_exp_f32 v48, v48
  v_exp_f32 v49, v49
  v_exp_f32 v50, v50
  v_exp_f32 v51, v51
  v_pk_add_f32 v[48:49], v[48:49], v[126:127]
  v_pk_add_f32 v[50:51], v[50:51], v[126:127]
  v_rcp_f32 v48, v48
  v_rcp_f32 v49, v49
  v_rcp_f32 v50, v50
  v_rcp_f32 v51, v51
  v_lshlrev_b32 v52, 16, v72
  v_lshlrev_b32 v53, 16, v73
  v_lshlrev_b32 v54, 16, v74
  v_lshlrev_b32 v55, 16, v75
  v_pk_fma_f32 v[44:45], v[52:53], v[48:49], v[44:45]
  v_pk_fma_f32 v[46:47], v[54:55], v[50:51], v[46:47]
  buffer_load_dwordx4 v[72:75], v[116:117], s[12:15], 0 idxen offen
  ds_read_u16 v116, v90 offset:34048
  ds_read_u16_d16_hi v100, v90 offset:33922
  s_add_u32 s44, s44, 1
  s_cmp_eq_u32 s44, s46
  s_cbranch_scc1 B_switch5
B_cont5:
  s_waitcnt vmcnt(7) lgkmcnt(6)
  v_pk_fma_f32 v[48:49], v[110:111], v[12:13], v[40:41] op_sel_hi:[0,1,1]
  v_pk_fma_f32 v[50:51], v[110:111], v[14:15], v[42:43] op_sel_hi:[0,1,1]
  v_pk_add_f32 v[48:49], v[48:49], v[76:77]
  v_pk_add_f32 v[50:51], v[50:51], v[78:79]
  v_exp_f32 v48, v48
  v_exp_f32 v49, v49
  v_exp_f32 v50, v50
  v_exp_f32 v51, v51
  v_pk_add_f32 v[48:49], v[48:49], v[126:127]
  v_pk_add_f32 v[50:51], v[50:51], v[126:127]
  v_rcp_f32 v48, v48
  v_rcp_f32 v49, v49
  v_rcp_f32 v50, v50
  v_rcp_f32 v51, v51
  v_lshlrev_b32 v52, 16, v76
  v_lshlrev_b32 v53, 16, v77
  v_lshlrev_b32 v54, 16, v78
  v_lshlrev_b32 v55, 16, v79
  v_pk_fma_f32 v[44:45], v[52:53], v[48:49], v[44:45]
  v_pk_fma_f32 v[46:47], v[54:55], v[50:51], v[46:47]
  buffer_load_dwordx4 v[76:79], v[118:119], s[12:15], 0 idxen offen
  ds_read_u16 v118, v90 offset:34064
  ds_read_u16_d16_hi v102, v90 offset:33938
  s_add_u32 s44, s44, 1
  s_cmp_eq_u32 s44, s46
  s_cbranch_scc1 B_switch6
B_cont6:
  s_waitcnt vmcnt(7) lgkmcnt(6)
  v_pk_fma_f32 v[48:49], v[112:113], v[12:13], v[40:41] op_sel_hi:[0,1,1]
  v_pk_fma_f32 v[50:51], v[112:113], v[14:15], v[42:43] op_sel_hi:[0,1,1]
  v_pk_add_f32 v[48:49], v[48:49], v[80:81]
  v_pk_add_f32 v[50:51], v[50:51], v[82:83]
  v_exp_f32 v48, v48
  v_exp_f32 v49, v49
  v_exp_f32 v50, v50
  v_exp_f32 v51, v51
  v_pk_add_f32 v[48:49], v[48:49], v[126:127]
  v_pk_add_f32 v[50:51], v[50:51], v[126:127]
  v_rcp_f32 v48, v48
  v_rcp_f32 v49, v49
  v_rcp_f32 v50, v50
  v_rcp_f32 v51, v51
  v_lshlrev_b32 v52, 16, v80
  v_lshlrev_b32 v53, 16, v81
  v_lshlrev_b32 v54, 16, v82
  v_lshlrev_b32 v55, 16, v83
  v_pk_fma_f32 v[44:45], v[52:53], v[48:49], v[44:45]
  v_pk_fma_f32 v[46:47], v[54:55], v[50:51], v[46:47]
  buffer_load_dwordx4 v[80:83], v[120:121], s[12:15], 0 idxen offen
  ds_read_u16 v120, v90 offset:34080
  ds_read_u16_d16_hi v104, v90 offset:33954
  s_add_u32 s44, s44, 1
  s_cmp_eq_u32 s44, s46
  s_cbranch_scc1 B_switch7
B_cont7:
  s_waitcnt vmcnt(7) lgkmcnt(6)
  v_pk_fma_f32 v[48:49], v[114:115], v[12:13], v[40:41] op_sel_hi:[0,1,1]
  v_pk_fma_f32 v[50:51], v[114:115], v[14:15], v[42:43] op_sel_hi:[0,1,1]
  v_pk_add_f32 v[48:49], v[48:49], v[84:85]
  v_pk_add_f32 v[50:51], v[50:51], v[86:87]
  v_exp_f32 v48, v48
  v_exp_f32 v49, v49
  v_exp_f32 v50, v50
  v_exp_f32 v51, v51
  v_pk_add_f32 v[48:49], v[48:49], v[126:127]
  v_pk_add_f32 v[50:51], v[50:51], v[126:127]
  v_rcp_f32 v48, v48
  v_rcp_f32 v49, v49
  v_rcp_f32 v50, v50
  v_rcp_f32 v51, v51
  v_lshlrev_b32 v52, 16, v84
  v_lshlrev_b32 v53, 16, v85
  v_lshlrev_b32 v54, 16, v86
  v_lshlrev_b32 v55, 16, v87
  v_pk_fma_f32 v[44:45], v[52:53], v[48:49], v[44:45]
  v_pk_fma_f32 v[46:47], v[54:55], v[50:51], v[46:47]
  buffer_load_dwordx4 v[84:87], v[122:123], s[12:15], 0 idxen offen
  ds_read_u16 v122, v90 offset:34096
  ds_read_u16_d16_hi v106, v90 offset:33970
  s_add_u32 s44, s44, 1
  v_add_u32 v90, 128, v90
  s_branch B_loop
B_switch0:
  s_nop 1
  v_permlane32_swap_b32 v44, v46
  v_permlane32_swap_b32 v45, v47
  s_nop 1
  v_add_f32 v44, v44, v46
  v_add_f32 v45, v45, v47
  s_nop 1
  v_permlane16_swap_b32 v44, v45
  s_nop 1
  v_add_f32 v44, v44, v45
  v_add_u32 v124, v124, v88
  ds_add_f32 v124, v44 offset:17408
  s_cmp_eq_u32 s44, s45
  s_cbranch_scc1 B_loop_end
  v_cmp_ge_u32 vcc, s44, v89
  s_nop 3
  s_bcnt1_i32_b64 s47, vcc
  v_readlane_b32 s46, v89, s47
  s_sub_u32 s47, s47, 1
  s_lshl_b32 s50, s47, 8
  v_add_u32 v124, s50, v1
  ds_read_b128 v[40:43], v124 offset:1024
  s_min_u32 s46, s46, s45
  v_mov_b32 v44, 0
  v_mov_b32 v45, 0
  v_mov_b32 v46, 0
  v_mov_b32 v47, 0
  s_waitcnt lgkmcnt(0)
  s_branch B_cont0
B_switch1:
  s_nop 1
  v_permlane32_swap_b32 v44, v46
  v_permlane32_swap_b32 v45, v47
  s_nop 1
  v_add_f32 v44, v44, v46
  v_add_f32 v45, v45, v47
  s_nop 1
  v_permlane16_swap_b32 v44, v45
  s_nop 1
  v_add_f32 v44, v44, v45
  v_add_u32 v124, v124, v88
  ds_add_f32 v124, v44 offset:17408
  s_cmp_eq_u32 s44, s45
  s_cbranch_scc1 B_loop_end
  v_cmp_ge_u32 vcc, s44, v89
  s_nop 3
  s_bcnt1_i32_b64 s47, vcc
  v_readlane_b32 s46, v89, s47
  s_sub_u32 s47, s47, 1
  s_lshl_b32 s50, s47, 8
  v_add_u32 v124, s50, v1
  ds_read_b128 v[40:43], v124 offset:1024
  s_min_u32 s46, s46, s45
  v_mov_b32 v44, 0
  v_mov_b32 v45, 0
  v_mov_b32 v46, 0
  v_mov_b32 v47, 0
  s_waitcnt lgkmcnt(0)
  s_branch B_cont1
B_switch2:
  s_nop 1
  v_permlane32_swap_b32 v44, v46
  v_permlane32_swap_b32 v45, v47
  s_nop 1
  v_add_f32 v44, v44, v46
  v_add_f32 v45, v45, v47
  s_nop 1
  v_permlane16_swap_b32 v44, v45
  s_nop 1
  v_add_f32 v44, v44, v45
  v_add_u32 v124, v124, v88
  ds_add_f32 v124, v44 offset:17408
  s_cmp_eq_u32 s44, s45
  s_cbranch_scc1 B_loop_end
  v_cmp_ge_u32 vcc, s44, v89
  s_nop 3
  s_bcnt1_i32_b64 s47, vcc
  v_readlane_b32 s46, v89, s47
  s_sub_u32 s47, s47, 1
  s_lshl_b32 s50, s47, 8
  v_add_u32 v124, s50, v1
  ds_read_b128 v[40:43], v124 offset:1024
  s_min_u32 s46, s46, s45
  v_mov_b32 v44, 0
  v_mov_b32 v45, 0
  v_mov_b32 v46, 0
  v_mov_b32 v47, 0
  s_waitcnt lgkmcnt(0)
  s_branch B_cont2
B_switch3:
  s_nop 1
  v_permlane32_swap_b32 v44, v46
  v_permlane32_swap_b32 v45, v47
  s_nop 1
  v_add_f32 v44, v44, v46
  v_add_f32 v45, v45, v47
  s_nop 1
  v_permlane16_swap_b32 v44, v45
  s_nop 1
  v_add_f32 v44, v44, v45
  v_add_u32 v124, v124, v88
  ds_add_f32 v124, v44 offset:17408
  s_cmp_eq_u32 s44, s45
  s_cbranch_scc1 B_loop_end
  v_cmp_ge_u32 vcc, s44, v89
  s_nop 3
  s_bcnt1_i32_b64 s47, vcc
  v_readlane_b32 s46, v89, s47
  s_sub_u32 s47, s47, 1
  s_lshl_b32 s50, s47, 8
  v_add_u32 v124, s50, v1
  ds_read_b128 v[40:43], v124 offset:1024
  s_min_u32 s46, s46, s45
  v_mov_b32 v44, 0
  v_mov_b32 v45, 0
  v_mov_b32 v46, 0
  v_mov_b32 v47, 0
  s_waitcnt lgkmcnt(0)
  s_branch B_cont3
B_switch4:
  s_nop 1
  v_permlane32_swap_b32 v44, v46
  v_permlane32_swap_b32 v45, v47
  s_nop 1
  v_add_f32 v44, v44, v46
  v_add_f32 v45, v45, v47
  s_nop 1
  v_permlane16_swap_b32 v44, v45
  s_nop 1
  v_add_f32 v44, v44, v45
  v_add_u32 v124, v124, v88
  ds_add_f32 v124, v44 offset:17408
  s_cmp_eq_u32 s44, s45
  s_cbranch_scc1 B_loop_end
  v_cmp_ge_u32 vcc, s44, v89
  s_nop 3
  s_bcnt1_i32_b64 s47, vcc
  v_readlane_b32 s46, v89, s47
  s_sub_u32 s47, s47, 1
  s_lshl_b32 s50, s47, 8
  v_add_u32 v124, s50, v1
  ds_read_b128 v[40:43], v124 offset:1024
  s_min_u32 s46, s46, s45
  v_mov_b32 v44, 0
  v_mov_b32 v45, 0
  v_mov_b32 v46, 0
  v_mov_b32 v47, 0
  s_waitcnt lgkmcnt(0)
  s_branch B_cont4
B_switch5:
  s_nop 1
  v_permlane32_swap_b32 v44, v46
  v_permlane32_swap_b32 v45, v47
  s_nop 1
  v_add_f32 v44, v44, v46
  v_add_f32 v45, v45, v47
  s_nop 1
  v_permlane16_swap_b32 v44, v45
  s_nop 1
  v_add_f32 v44, v44, v45
  v_add_u32 v124, v124, v88
  ds_add_f32 v124, v44 offset:17408
  s_cmp_eq_u32 s44, s45
  s_cbranch_scc1 B_loop_end
  v_cmp_ge_u32 vcc, s44, v89
  s_nop 3
  s_bcnt1_i32_b64 s47, vcc
  v_readlane_b32 s46, v89, s47
  s_sub_u32 s47, s47, 1
  s_lshl_b32 s50, s47, 8
  v_add_u32 v124, s50, v1
  ds_read_b128 v[40:43], v124 offset:1024
  s_min_u32 s46, s46, s45
  v_mov_b32 v44, 0
  v_mov_b32 v45, 0
  v_mov_b32 v46, 0
  v_mov_b32 v47, 0
  s_waitcnt lgkmcnt(0)
  s_branch B_cont5
B_switch6:
  s_nop 1
  v_permlane32_swap_b32 v44, v46
  v_permlane32_swap_b32 v45, v47
  s_nop 1
  v_add_f32 v44, v44, v46
  v_add_f32 v45, v45, v47
  s_nop 1
  v_permlane16_swap_b32 v44, v45
  s_nop 1
  v_add_f32 v44, v44, v45
  v_add_u32 v124, v124, v88
  ds_add_f32 v124, v44 offset:17408
  s_cmp_eq_u32 s44, s45
  s_cbranch_scc1 B_loop_end
  v_cmp_ge_u32 vcc, s44, v89
  s_nop 3
  s_bcnt1_i32_b64 s47, vcc
  v_readlane_b32 s46, v89, s47
  s_sub_u32 s47, s47, 1
  s_lshl_b32 s50, s47, 8
  v_add_u32 v124, s50, v1
  ds_read_b128 v[40:43], v124 offset:1024
  s_min_u32 s46, s46, s45
  v_mov_b32 v44, 0
  v_mov_b32 v45, 0
  v_mov_b32 v46, 0
  v_mov_b32 v47, 0
  s_waitcnt lgkmcnt(0)
  s_branch B_cont6
B_switch7:
  s_nop 1
  v_permlane32_swap_b32 v44, v46
  v_permlane32_swap_b32 v45, v47
  s_nop 1
  v_add_f32 v44, v44, v46
  v_add_f32 v45, v45, v47
  s_nop 1
  v_permlane16_swap_b32 v44, v45
  s_nop 1
  v_add_f32 v44, v44, v45
  v_add_u32 v124, v124, v88
  ds_add_f32 v124, v44 offset:17408
  s_cmp_eq_u32 s44, s45
  s_cbranch_scc1 B_loop_end
  v_cmp_ge_u32 vcc, s44, v89
  s_nop 3
  s_bcnt1_i32_b64 s47, vcc
  v_readlane_b32 s46, v89, s47
  s_sub_u32 s47, s47, 1
  s_lshl_b32 s50, s47, 8
  v_add_u32 v124, s50, v1
  ds_read_b128 v[40:43], v124 offset:1024
  s_min_u32 s46, s46, s45
  v_mov_b32 v44, 0
  v_mov_b32 v45, 0
  v_mov_b32 v46, 0
  v_mov_b32 v47, 0
  s_waitcnt lgkmcnt(0)
  s_branch B_cont7
B_loop_end:
  s_setprio 0
  s_waitcnt vmcnt(0) lgkmcnt(0)
  s_barrier
  s_add_u32 s41, s41, 32
  s_cmp_lt_u32 s41, s42
  s_cbranch_scc1 B_layer
  v_cmp_gt_u32 vcc, 800, v0
  s_and_saveexec_b64 s[54:55], vcc
  s_cbranch_execz B_epi_end
  ds_read_b128 v[40:43], v91 offset:17408
  s_waitcnt lgkmcnt(0)
  v_mul_f32 v44, s51, v40
  v_mul_f32 v45, s51, v41
  v_mul_f32 v46, s51, v42
  v_mul_f32 v47, s51, v43
  v_exp_f32 v44, v44
  v_exp_f32 v45, v45
  v_exp_f32 v46, v46
  v_exp_f32 v47, v47
  s_nop 0
  v_add_f32 v44, 1.0, v44
  v_add_f32 v45, 1.0, v45
  v_add_f32 v46, 1.0, v46
  v_add_f32 v47, 1.0, v47
  v_rcp_f32 v44, v44
  v_rcp_f32 v45, v45
  v_rcp_f32 v46, v46
  v_rcp_f32 v47, v47
  s_nop 0
  v_mul_f32 v40, v40, v44
  v_mul_f32 v41, v41, v45
  v_mul_f32 v42, v42, v46
  v_mul_f32 v43, v43, v47
  v_cvt_pk_bf16_f32 v48, v40, v41
  v_cvt_pk_bf16_f32 v49, v42, v43
  v_lshlrev_b32 v50, 3, v0
  s_mul_i32 s52, s2, 6400
  buffer_store_dwordx2 v[48:49], v50, s[32:35], s52 offen sc1
B_epi_end:
B_done:
  s_endpgm
.section .rodata,"a"
.p2align 6
.amdhsa_kernel prep_kernel
  .amdhsa_next_free_vgpr 88
  .amdhsa_next_free_sgpr 56
  .amdhsa_accum_offset 88
  .amdhsa_group_segment_fixed_size 0
  .amdhsa_kernarg_size 80
  .amdhsa_user_sgpr_count 2
  .amdhsa_user_sgpr_kernarg_segment_ptr 1
  .amdhsa_system_sgpr_workgroup_id_x 1
.end_amdhsa_kernel
.p2align 6
.amdhsa_kernel agg_kernel
  .amdhsa_next_free_vgpr 128
  .amdhsa_next_free_sgpr 100
  .amdhsa_accum_offset 128
  .amdhsa_group_segment_fixed_size 0
  .amdhsa_kernarg_size 80
  .amdhsa_user_sgpr_count 2
  .amdhsa_user_sgpr_kernarg_segment_ptr 1
  .amdhsa_system_sgpr_workgroup_id_x 1
.end_amdhsa_kernel
```
